```python
import torch

def _softmax(x, axis=-1):
    return torch.softmax(x, dim=axis)
def _gelu(x):
    return torch.nn.functional.gelu(x, approximate="tanh")
def _silu(x):
    return torch.nn.functional.silu(x)
def _sigmoid(x):
    return torch.sigmoid(x)
def _layernorm(x, axis=-1, eps=1e-5):
    m = x.mean(dim=axis, keepdim=True)
    v = x.var(dim=axis, keepdim=True, unbiased=False)
    return (x - m) / torch.sqrt(v + eps)
def _scatter_add(tgt, idx, src, axis=0):
    return tgt.clone().index_add_(axis, idx, src)
def _segment_sum(src, seg, n):
    out = torch.zeros((n,) + src.shape[1:], dtype=src.dtype)
    return out.index_add_(0, seg, src)
def _pad(x, pw):
    flat = tuple(v for pair in reversed(pw) for v in pair)
    return torch.nn.functional.pad(x, flat)

kernel_name = 'standalone__paged_block_table_kv_radixattention__decode'

def setup_inputs():

    _w = (lambda a: (lambda t: t.to(torch.bfloat16) if t.is_floating_point() else t)(torch.as_tensor(a)))
    B, H, Hkv, Dh = 4, 32, 8, 128
    Lk = 16384
    bs = 16
    nb = max(2, Lk // bs)
    P = max(1, nb // 2)
    n_phys = P + B * (nb - P)
    shared = torch.arange(P, dtype=torch.int64)
    priv = P + torch.arange(B * (nb - P), dtype=torch.int64).reshape(B, nb - P)
    bt = torch.cat([torch.tile(shared[None, :], (B, 1)), priv], dim=1)
    ctx = nb * bs - (torch.arange(1, B + 1, dtype=torch.int64) * 2654435761) % max(1, (nb * bs - P * bs) // 2)
    return {
        "q": _w((lambda *s: torch.randn(*s, dtype=torch.bfloat16) * 0.8)(B, H, Dh)),
        "k_cache": _w((lambda *s: torch.randn(*s, dtype=torch.bfloat16) * 0.8)(n_phys, bs, Hkv, Dh)),
        "v_cache": _w((lambda *s: torch.randn(*s, dtype=torch.bfloat16) * 0.05)(n_phys, bs, Hkv, Dh)),
        "block_table": _w(bt.to(torch.int64)),
        "ctx_lens": _w(torch.as_tensor(ctx).to(torch.int64)),
    }

def reference(q, k_cache, v_cache, block_table, ctx_lens):
    B, H, Dh = q.shape
    n_phys, bs, Hkv, _ = k_cache.shape
    nb = block_table.shape[1]
    Lk = nb * bs
    rep = H // Hkv
    k = k_cache[block_table].reshape(B, Lk, Hkv, Dh)
    v = v_cache[block_table].reshape(B, Lk, Hkv, Dh)
    k = (lambda x, n, axis: torch.repeat_interleave(x, n, dim=axis))(k, rep, axis=2)
    v = (lambda x, n, axis: torch.repeat_interleave(x, n, dim=axis))(v, rep, axis=2)
    scores = torch.einsum("bhd,bkhd->bhk", q, k) * (Dh ** -0.5)
    pos = torch.arange(Lk)
    valid = pos[None, :] < ctx_lens[:, None]
    scores = torch.where(valid[:, None, :], scores, -1e9)
    p = _softmax(scores, axis=-1)
    return torch.einsum("bhk,bkhd->bhd", p, v)
```

```asm
; @launch grid=(256,1,1) block=(768,1,1) lds=78080
.amdgcn_target "amdgcn-amd-amdhsa--gfx950"
.text
.globl standalone__paged_block_table_kv_radixattention__decode_kernel
.p2align 8
.type standalone__paged_block_table_kv_radixattention__decode_kernel,@function
standalone__paged_block_table_kv_radixattention__decode_kernel:
  s_cmp_ge_u32 s2, 256
  s_cbranch_scc1 L_end
  v_lshrrev_b32 v2, 6, v0
  v_mov_b32 v30, 0
  v_readfirstlane_b32 s3, v2
  v_and_b32 v1, 63, v0
  s_cmp_lg_u32 s3, 8
  s_cbranch_scc1 L_nz
  ds_write_b32 v30, v30 offset:1032
  s_waitcnt lgkmcnt(0)
L_nz:
  s_load_dwordx16 s[16:31], s[0:1], 0
  s_and_b32 s7, s2, 3
  s_lshr_b32 s6, s2, 2
  s_lshl_b32 s76, s7, 7
  s_cmp_ge_u32 s3, 8
  s_barrier
  s_cbranch_scc1 L_helper
  s_cmp_lt_u32 s3, 4
  s_cbranch_scc1 L_wret
  s_mov_b64 exec, 0
  s_cmp_eq_u32 s3, 4
  s_cbranch_scc1 L_wreg_0
  s_cmp_eq_u32 s3, 5
  s_cbranch_scc1 L_wreg_1
  s_cmp_eq_u32 s3, 6
  s_cbranch_scc1 L_wreg_2
  s_branch L_wreg_3
L_wret:
  s_mov_b64 exec, -1
  s_lshl_b32 s40, s3, 2
  s_lshr_b32 s3, 0x64207531, s40
  s_and_b32 s3, s3, 7
  s_mul_i32 s98, s6, 2034
  s_lshr_b32 s98, s98, 6
  v_lshrrev_b32 v2, 4, v1
  v_and_b32 v3, 15, v1
  s_and_b32 s101, s3, 1
  s_lshl_b32 s4, s7, 1
  s_add_u32 s4, s4, s101
  s_lshr_b32 s5, s3, 1
  s_lshl_b32 s39, s3, 13
  s_add_u32 s39, s39, 12544
  v_add_u32 v21, 0, v2
  v_xor_b32 v22, v21, v3
  v_lshlrev_b32 v22, 4, v22
  v_lshl_add_u32 v4, v21, 11, v22
  v_add_u32 v21, 4, v2
  v_xor_b32 v22, v21, v3
  v_lshlrev_b32 v22, 4, v22
  v_lshl_add_u32 v5, v21, 11, v22
  v_subrev_u32 v5, 1024, v5
  v_add_u32 v21, 8, v2
  v_xor_b32 v22, v21, v3
  v_lshlrev_b32 v22, 4, v22
  v_lshl_add_u32 v6, v21, 11, v22
  v_subrev_u32 v6, 2048, v6
  v_add_u32 v21, 12, v2
  v_xor_b32 v22, v21, v3
  v_lshlrev_b32 v22, 4, v22
  v_lshl_add_u32 v7, v21, 11, v22
  v_subrev_u32 v7, 3072, v7
  s_lshl_b32 s96, s4, 8
  s_add_u32 s98, s98, s5
  s_add_u32 s90, s98, 0
  s_cmp_ge_u32 s90, 869
  s_cselect_b32 s93, 155, 0
  s_cmp_ge_u32 s90, 1327
  s_cselect_b32 s93, 209, s93
  s_cmp_ge_u32 s90, 1630
  s_cselect_b32 s93, 418, s93
  s_add_u32 s90, s90, s93
  s_lshl_b32 s90, s90, 15
  s_add_u32 s90, s90, s96
  s_mov_b32 s10, 0x5000000
  s_mov_b32 s14, 0x5000000
  s_mov_b32 s11, 0x20000
  s_mov_b32 m0, s39
  v_lshlrev_b32 v21, 13, v2
  v_lshl_add_u32 v8, v3, 4, v21
  v_add_u32 v9, 0x1000, v8
  s_mov_b32 s15, 0x20000
  s_waitcnt lgkmcnt(0)
  s_mov_b32 s8, s18
  s_and_b32 s9, s19, 0xffff
  buffer_load_dwordx4 v4, s[8:11], s90 offen offset:0 nt lds
  buffer_load_dwordx4 v5, s[8:11], s90 offen offset:1024 nt lds
  buffer_load_dwordx4 v6, s[8:11], s90 offen offset:2048 nt lds
  buffer_load_dwordx4 v7, s[8:11], s90 offen offset:3072 nt lds
  s_load_dwordx4 s[32:35], s[24:25], 0
  s_load_dword s76, s[30:31], s76
  s_mov_b32 s12, s20
  s_and_b32 s13, s21, 0xffff
  s_lshl_b32 s93, s5, 2
  v_add_u32 v21, s93, v2
  v_xor_b32 v21, v21, v3
  v_lshlrev_b32 v21, 4, v21
  v_lshl_add_u32 v21, v2, 8, v21
  s_lshl_b32 s93, s5, 13
  s_lshl_b32 s94, s4, 10
  s_add_u32 s93, s93, s94
  v_add_u32 v23, s93, v21
  s_lshl_b32 s101, s101, 12
  s_lshl_b32 s93, s5, 10
  s_add_u32 s93, s93, s101
  s_add_u32 m0, s93, 4352
  s_add_u32 s91, s98, 4
  s_cmp_ge_u32 s91, 869
  s_cselect_b32 s93, 155, 0
  s_cmp_ge_u32 s91, 1327
  s_cselect_b32 s93, 209, s93
  s_cmp_ge_u32 s91, 1630
  s_cselect_b32 s93, 418, s93
  s_add_u32 s91, s91, s93
  s_lshl_b32 s91, s91, 15
  s_add_u32 s91, s91, s96
  global_load_lds_dwordx4 v23, s[16:17]
L_wreg_0:
L_pad_0:
  s_cbranch_execz L_pad_1
  buffer_load_dwordx4 v[64:67], v8, s[12:15], s90 offen offset:0 nt
  buffer_load_dwordx4 v[68:71], v8, s[12:15], s90 offen offset:2048 nt
  buffer_load_dwordx4 v[72:75], v9, s[12:15], s90 offen offset:0 nt
  buffer_load_dwordx4 v[76:79], v9, s[12:15], s90 offen offset:2048 nt
  s_mov_b32 s36, 0x3e0293ee
  s_mov_b32 s37, 0x05040100
  s_mov_b32 s38, 0x07060302
  v_lshrrev_b32 v30, 2, v3
  v_lshlrev_b32 v14, 3, v30
  v_lshlrev_b32 v15, 2, v2
  v_mov_b32 v16, 0xff800000
  v_mov_b32 v17, 0xf149f2ca
  v_mov_b32 v18, 0
  v_xor_b32 v21, v2, v3
  v_lshlrev_b32 v21, 4, v21
  v_lshl_add_u32 v21, v3, 8, v21
  v_add_u32 v10, s39, v21
  v_xor_b32 v11, 64, v10
  v_xor_b32 v12, 0x80, v10
  v_xor_b32 v13, 0xc0, v10
  v_add_u32 v48, s101, v21
  v_xor_b32 v49, 64, v48
  v_xor_b32 v50, 0x80, v48
  v_xor_b32 v51, 0xc0, v48
  v_mov_b32 v96, 0
  v_mov_b32 v97, 0
  v_mov_b32 v98, 0
  v_mov_b32 v99, 0
  v_mov_b32 v100, 0
  v_mov_b32 v101, 0
  v_mov_b32 v102, 0
  v_mov_b32 v103, 0
  v_mov_b32 v104, 0
  v_mov_b32 v105, 0
  v_mov_b32 v106, 0
  v_mov_b32 v107, 0
  v_mov_b32 v108, 0
  v_mov_b32 v109, 0
  v_mov_b32 v110, 0
  v_mov_b32 v111, 0
  v_mov_b32 v112, 0
  v_mov_b32 v113, 0
  v_mov_b32 v114, 0
  v_mov_b32 v115, 0
  v_mov_b32 v116, 0
  v_mov_b32 v117, 0
  v_mov_b32 v118, 0
  v_mov_b32 v119, 0
  v_mov_b32 v120, 0
  v_mov_b32 v121, 0
  v_mov_b32 v122, 0
  v_mov_b32 v123, 0
  v_mov_b32 v124, 0
  v_mov_b32 v125, 0
  v_mov_b32 v126, 0
  v_mov_b32 v127, 0
  v_lshrrev_b32 v21, 4, v1
  v_and_b32 v22, 15, v1
  v_lshlrev_b32 v128, 9, v22
  v_lshl_add_u32 v128, v21, 7, v128
  v_and_b32 v31, 7, v22
  v_lshl_add_u32 v128, v31, 4, v128
  v_add_u32 v128, s39, v128
  s_and_b32 s99, s3, 1
  s_lshl_b32 s64, s99, 9
  s_lshl_b32 s93, s5, 3
  s_add_u32 s93, s93, s64
  v_lshlrev_b32 v129, 5, v22
  v_add_u32 v129, s93, v129
  s_lshl_b32 s93, s5, 2
  v_add_u32 v21, s93, v21
  v_and_b32 v130, 7, v21
  v_xor_b32 v130, v130, v22
  v_lshlrev_b32 v130, 4, v130
  v_lshl_add_u32 v130, v21, 9, v130
  s_lshl_b32 s93, s99, 13
  v_add_u32 v130, s93, v130
  v_lshlrev_b32 v131, 5, v21
  v_add_u32 v131, s64, v131
  s_lshl_b32 s93, s7, 5
  s_lshl_b32 s64, s99, 4
  s_add_u32 s93, s93, s64
  s_mul_i32 s93, s93, 50432
  s_mul_i32 s64, s6, 768
  s_add_u32 s93, s93, s64
  s_add_u32 s93, s93, 65536
  s_mov_b32 s64, 50432
  v_mul_lo_u32 v21, v21, s64
  v_add_u32 v21, s93, v21
  v_lshl_add_u32 v132, v22, 4, v21
  v_lshrrev_b32 v133, 3, v22
  v_lshl_add_u32 v133, v133, 8, v132
  v_mov_b32 v134, 0xff
  s_add_u32 m0, s39, 4096
  s_nop 0
  buffer_load_dwordx4 v4, s[8:11], s91 offen offset:0 nt lds
  buffer_load_dwordx4 v5, s[8:11], s91 offen offset:1024 nt lds
L_pad_1:
  s_cbranch_execz L_pad_2
  buffer_load_dwordx4 v6, s[8:11], s91 offen offset:2048 nt lds
  buffer_load_dwordx4 v7, s[8:11], s91 offen offset:3072 nt lds
  buffer_load_dwordx4 v[80:83], v8, s[12:15], s91 offen offset:0 nt
  buffer_load_dwordx4 v[84:87], v8, s[12:15], s91 offen offset:2048 nt
  buffer_load_dwordx4 v[88:91], v9, s[12:15], s91 offen offset:0 nt
  buffer_load_dwordx4 v[92:95], v9, s[12:15], s91 offen offset:2048 nt
  v_lshlrev_b32 v21, 5, v1
  s_lshl_b32 s93, s5, 3
  v_add_u32 v21, s93, v21
  v_and_b32 v21, 0x1ff, v21
  v_mov_b32 v22, 0
  s_waitcnt lgkmcnt(0)
  s_mov_b32 s100, 0
  s_cmp_lt_i32 s32, 1
  s_cselect_b32 s93, 1, 0
  s_or_b32 s100, s100, s93
  s_cmp_lt_i32 s33, 1
  s_cselect_b32 s93, 256, 0
  s_or_b32 s100, s100, s93
  s_cmp_lt_i32 s34, 1
  s_cselect_b32 s93, 65536, 0
  s_or_b32 s100, s100, s93
  s_cmp_lt_i32 s35, 1
  s_cselect_b32 s93, 16777216, 0
  s_or_b32 s100, s100, s93
  s_and_b32 s72, s76, 0xff
  s_add_u32 s72, s72, 1
  s_cmp_eq_u32 s72, 0x100
  s_cselect_b32 s72, 1, s72
  s_bfe_u32 s73, s76, 0x80008
  s_max_u32 s73, s73, 1
  s_bfe_u32 s74, s76, 0x80010
  s_max_u32 s74, s74, 1
  s_lshr_b32 s75, s76, 24
  s_max_u32 s75, s75, 1
  s_xor_b32 s70, s76, 0x9e3779b9
  s_mul_i32 s71, s76, 0x85ebca6b
  s_add_u32 s71, s71, 0x6a09e667
  v_mov_b32 v138, s70
  v_mov_b32 v139, s71
  v_bfe_u32 v2, s100, v14, 1
  v_add_u32 v2, -1, v2
  s_waitcnt vmcnt(12)
  s_barrier
  ds_read_b64 v[30:31], v21 offset:1280
  ds_read_b64 v[28:29], v22 offset:1024
  ds_read_b128 v[32:35], v48 offset:4352
  ds_read_b128 v[36:39], v49 offset:4352
  ds_read_b128 v[40:43], v50 offset:4352
  ds_read_b128 v[44:47], v51 offset:4352
  s_waitcnt lgkmcnt(4)
  v_min_u32 v30, 2559, v30
  v_readfirstlane_b32 s99, v28
  v_readfirstlane_b32 s97, v29
  v_lshlrev_b32 v30, 15, v30
  v_add_u32 v19, s96, v30
  v_mov_b32 v20, v31
  s_sub_u32 s92, s99, s5
  v_readlane_b32 s66, v19, 0
  v_readlane_b32 s67, v19, 1
  s_add_u32 s92, s92, 3
  s_lshr_b32 s92, s92, 2
  s_waitcnt lgkmcnt(0)
  v_and_b32 v32, v2, v32
  v_and_b32 v33, v2, v33
  v_and_b32 v34, v2, v34
  v_and_b32 v35, v2, v35
  v_and_b32 v36, v2, v36
  v_and_b32 v37, v2, v37
  v_and_b32 v38, v2, v38
  v_and_b32 v39, v2, v39
  v_and_b32 v40, v2, v40
  v_and_b32 v41, v2, v41
  v_and_b32 v42, v2, v42
  v_and_b32 v43, v2, v43
  v_and_b32 v44, v2, v44
  v_and_b32 v45, v2, v45
  v_and_b32 v46, v2, v46
  v_and_b32 v47, v2, v47
  s_cmp_lt_u32 s92, 2
  s_cbranch_scc1 L_miss
  s_cmp_lg_u32 s66, s90
  s_cbranch_scc1 L_miss
  s_cmp_eq_u32 s67, s91
  s_cbranch_scc1 L_go
L_miss:
  s_waitcnt vmcnt(0)
  s_cmp_le_u32 s92, 0
  s_cbranch_scc1 L_go
  s_add_u32 m0, s39, 0
  s_nop 0
  buffer_load_dwordx4 v4, s[8:11], s66 offen offset:0 nt lds
  buffer_load_dwordx4 v5, s[8:11], s66 offen offset:1024 nt lds
  buffer_load_dwordx4 v6, s[8:11], s66 offen offset:2048 nt lds
  buffer_load_dwordx4 v7, s[8:11], s66 offen offset:3072 nt lds
L_pad_2:
  s_cbranch_execz L_wret
  buffer_load_dwordx4 v[64:67], v8, s[12:15], s66 offen offset:0 nt
  buffer_load_dwordx4 v[68:71], v8, s[12:15], s66 offen offset:2048 nt
  buffer_load_dwordx4 v[72:75], v9, s[12:15], s66 offen offset:0 nt
  buffer_load_dwordx4 v[76:79], v9, s[12:15], s66 offen offset:2048 nt
  s_cmp_le_u32 s92, 1
  s_cbranch_scc1 L_go
  s_add_u32 m0, s39, 4096
  s_nop 0
  buffer_load_dwordx4 v4, s[8:11], s67 offen offset:0 nt lds
  buffer_load_dwordx4 v5, s[8:11], s67 offen offset:1024 nt lds
  buffer_load_dwordx4 v6, s[8:11], s67 offen offset:2048 nt lds
  buffer_load_dwordx4 v7, s[8:11], s67 offen offset:3072 nt lds
  buffer_load_dwordx4 v[80:83], v8, s[12:15], s67 offen offset:0 nt
  buffer_load_dwordx4 v[84:87], v8, s[12:15], s67 offen offset:2048 nt
  buffer_load_dwordx4 v[88:91], v9, s[12:15], s67 offen offset:0 nt
  buffer_load_dwordx4 v[92:95], v9, s[12:15], s67 offen offset:2048 nt
L_go:
  s_mov_b32 s93, 0
  s_mov_b32 s94, s92
  s_cmp_eq_u32 s92, 0
  s_cbranch_scc1 L_done
L_loop:
  s_add_u32 s64, s93, 2
  v_readlane_b32 s95, v19, s64
  v_readlane_b32 s96, v20, s93
  s_add_u32 m0, s39, 0
  s_cmp_eq_u32 s94, 1
  s_cbranch_scc0 L_k12_0
  s_waitcnt vmcnt(4)
L_k12_0:
  s_waitcnt vmcnt(12)
  ds_read_b128 v[48:51], v10 offset:0
  ds_read_b128 v[52:55], v11 offset:0
  ds_read_b128 v[56:59], v12 offset:0
  ds_read_b128 v[60:63], v13 offset:0
  v_bfe_u32 v2, s96, v14, 8
  v_sub_u32 v2, v2, v15
  v_cmp_lt_i32 s[56:57], 0, v2
  v_cmp_lt_i32 s[58:59], 1, v2
  v_cmp_lt_i32 s[60:61], 2, v2
  v_cmp_lt_i32 s[62:63], 3, v2
  s_cmp_le_u32 s94, 2
  s_waitcnt lgkmcnt(3)
  v_mfma_f32_16x16x32_bf16 v[24:27], v[48:51], v[32:35], 0
  s_waitcnt lgkmcnt(2)
  v_mfma_f32_16x16x32_bf16 v[24:27], v[52:55], v[36:39], v[24:27]
  s_waitcnt lgkmcnt(1)
  v_mfma_f32_16x16x32_bf16 v[24:27], v[56:59], v[40:43], v[24:27]
  s_waitcnt lgkmcnt(0)
  v_mfma_f32_16x16x32_bf16 v[24:27], v[60:63], v[44:47], v[24:27]
  s_cbranch_scc1 L_nk_0
  buffer_load_dwordx4 v4, s[8:11], s95 offen offset:0 nt lds
  buffer_load_dwordx4 v5, s[8:11], s95 offen offset:1024 nt lds
  buffer_load_dwordx4 v6, s[8:11], s95 offen offset:2048 nt lds
  buffer_load_dwordx4 v7, s[8:11], s95 offen offset:3072 nt lds
L_nk_0:
  s_nop 6
  v_cndmask_b32 v24, v16, v24, s[56:57]
  v_cndmask_b32 v25, v16, v25, s[58:59]
  v_cndmask_b32 v26, v16, v26, s[60:61]
  v_cndmask_b32 v27, v16, v27, s[62:63]
  v_max3_f32 v2, v24, v25, v26
  v_max3_f32 v2, v2, v27, v17
  v_mov_b32 v3, v2
  s_nop 1
  v_permlane32_swap_b32 v2, v3
  v_max_f32 v2, v2, v3
  v_mov_b32 v3, v2
  s_nop 1
  v_permlane16_swap_b32 v2, v3
  v_max_f32 v2, v2, v3
  v_sub_f32 v3, v17, v2
  v_mul_f32 v21, s36, v2
  v_mul_f32 v3, s36, v3
  v_mov_b32 v17, v2
  v_exp_f32 v23, v3
  v_fma_f32 v24, v24, s36, -v21
  v_fma_f32 v25, v25, s36, -v21
  v_fma_f32 v26, v26, s36, -v21
  v_fma_f32 v27, v27, s36, -v21
  v_exp_f32 v24, v24
  v_exp_f32 v25, v25
  v_exp_f32 v26, v26
  v_exp_f32 v27, v27
  v_cmp_neq_f32 vcc, 1.0, v23
  v_add_f32 v2, v24, v25
  v_add_f32 v3, v26, v27
L_wreg_1:
L_pad_3:
  s_cbranch_execz L_pad_4
  v_cvt_pk_bf16_f32 v28, v24, v25
  v_cvt_pk_bf16_f32 v29, v26, v27
  v_add_f32 v2, v2, v3
  v_fma_f32 v18, v18, v23, v2
  s_cbranch_vccz L_nors_0
  v_pk_mul_f32 v[96:97], v[22:23], v[96:97] op_sel:[1,0] op_sel_hi:[1,1]
  v_pk_mul_f32 v[98:99], v[22:23], v[98:99] op_sel:[1,0] op_sel_hi:[1,1]
  v_pk_mul_f32 v[100:101], v[22:23], v[100:101] op_sel:[1,0] op_sel_hi:[1,1]
  v_pk_mul_f32 v[102:103], v[22:23], v[102:103] op_sel:[1,0] op_sel_hi:[1,1]
  v_pk_mul_f32 v[104:105], v[22:23], v[104:105] op_sel:[1,0] op_sel_hi:[1,1]
  v_pk_mul_f32 v[106:107], v[22:23], v[106:107] op_sel:[1,0] op_sel_hi:[1,1]
  v_pk_mul_f32 v[108:109], v[22:23], v[108:109] op_sel:[1,0] op_sel_hi:[1,1]
  v_pk_mul_f32 v[110:111], v[22:23], v[110:111] op_sel:[1,0] op_sel_hi:[1,1]
  v_pk_mul_f32 v[112:113], v[22:23], v[112:113] op_sel:[1,0] op_sel_hi:[1,1]
  v_pk_mul_f32 v[114:115], v[22:23], v[114:115] op_sel:[1,0] op_sel_hi:[1,1]
  v_pk_mul_f32 v[116:117], v[22:23], v[116:117] op_sel:[1,0] op_sel_hi:[1,1]
  v_pk_mul_f32 v[118:119], v[22:23], v[118:119] op_sel:[1,0] op_sel_hi:[1,1]
  v_pk_mul_f32 v[120:121], v[22:23], v[120:121] op_sel:[1,0] op_sel_hi:[1,1]
  v_pk_mul_f32 v[122:123], v[22:23], v[122:123] op_sel:[1,0] op_sel_hi:[1,1]
  v_pk_mul_f32 v[124:125], v[22:23], v[124:125] op_sel:[1,0] op_sel_hi:[1,1]
  v_pk_mul_f32 v[126:127], v[22:23], v[126:127] op_sel:[1,0] op_sel_hi:[1,1]
L_nors_0:
  s_cmp_gt_u32 s94, 2
  s_cbranch_scc1 L_v12_0
  s_cmp_eq_u32 s94, 2
  s_cbranch_scc1 L_v8_0
  s_waitcnt vmcnt(0)
L_v8_0:
  s_waitcnt vmcnt(8)
L_v12_0:
  s_waitcnt vmcnt(12)
  s_cmp_le_u32 s94, 2
  v_perm_b32 v48, v68, v64, s37
  v_perm_b32 v49, v76, v72, s37
  v_perm_b32 v50, v68, v64, s38
  v_perm_b32 v51, v76, v72, s38
  v_perm_b32 v52, v69, v65, s37
  v_perm_b32 v53, v77, v73, s37
  v_perm_b32 v54, v69, v65, s38
  v_perm_b32 v55, v77, v73, s38
  v_perm_b32 v56, v70, v66, s37
  v_perm_b32 v57, v78, v74, s37
  v_perm_b32 v58, v70, v66, s38
  v_perm_b32 v59, v78, v74, s38
  v_perm_b32 v60, v71, v67, s37
  v_perm_b32 v61, v79, v75, s37
  v_perm_b32 v62, v71, v67, s38
  v_perm_b32 v63, v79, v75, s38
  s_cbranch_scc1 L_nv_0
  buffer_load_dwordx4 v[64:67], v8, s[12:15], s95 offen offset:0 nt
  buffer_load_dwordx4 v[68:71], v8, s[12:15], s95 offen offset:2048 nt
  buffer_load_dwordx4 v[72:75], v9, s[12:15], s95 offen offset:0 nt
  buffer_load_dwordx4 v[76:79], v9, s[12:15], s95 offen offset:2048 nt
L_nv_0:
  s_add_u32 s93, s93, 1
  v_mfma_f32_16x16x16_bf16 v[96:99], v[48:49], v[28:29], v[96:99]
  v_mfma_f32_16x16x16_bf16 v[100:103], v[50:51], v[28:29], v[100:103]
  v_mfma_f32_16x16x16_bf16 v[104:107], v[52:53], v[28:29], v[104:107]
  v_mfma_f32_16x16x16_bf16 v[108:111], v[54:55], v[28:29], v[108:111]
  v_mfma_f32_16x16x16_bf16 v[112:115], v[56:57], v[28:29], v[112:115]
  v_mfma_f32_16x16x16_bf16 v[116:119], v[58:59], v[28:29], v[116:119]
  v_mfma_f32_16x16x16_bf16 v[120:123], v[60:61], v[28:29], v[120:123]
  v_mfma_f32_16x16x16_bf16 v[124:127], v[62:63], v[28:29], v[124:127]
  s_sub_u32 s94, s94, 1
  s_cmp_eq_u32 s94, 0
  s_cbranch_scc1 L_done
  s_add_u32 s64, s93, 2
  v_readlane_b32 s95, v19, s64
  v_readlane_b32 s96, v20, s93
  s_add_u32 m0, s39, 4096
  s_cmp_eq_u32 s94, 1
  s_cbranch_scc0 L_k12_1
  s_waitcnt vmcnt(4)
L_k12_1:
  s_waitcnt vmcnt(12)
  ds_read_b128 v[48:51], v10 offset:4096
  ds_read_b128 v[52:55], v11 offset:4096
  ds_read_b128 v[56:59], v12 offset:4096
L_pad_4:
  s_cbranch_execz L_wret
  ds_read_b128 v[60:63], v13 offset:4096
  v_bfe_u32 v2, s96, v14, 8
  v_sub_u32 v2, v2, v15
  v_cmp_lt_i32 s[56:57], 0, v2
  v_cmp_lt_i32 s[58:59], 1, v2
  v_cmp_lt_i32 s[60:61], 2, v2
  v_cmp_lt_i32 s[62:63], 3, v2
  s_cmp_le_u32 s94, 2
  s_waitcnt lgkmcnt(3)
  v_mfma_f32_16x16x32_bf16 v[24:27], v[48:51], v[32:35], 0
  s_waitcnt lgkmcnt(2)
  v_mfma_f32_16x16x32_bf16 v[24:27], v[52:55], v[36:39], v[24:27]
  s_waitcnt lgkmcnt(1)
  v_mfma_f32_16x16x32_bf16 v[24:27], v[56:59], v[40:43], v[24:27]
  s_waitcnt lgkmcnt(0)
  v_mfma_f32_16x16x32_bf16 v[24:27], v[60:63], v[44:47], v[24:27]
  s_cbranch_scc1 L_nk_1
  buffer_load_dwordx4 v4, s[8:11], s95 offen offset:0 nt lds
  buffer_load_dwordx4 v5, s[8:11], s95 offen offset:1024 nt lds
  buffer_load_dwordx4 v6, s[8:11], s95 offen offset:2048 nt lds
  buffer_load_dwordx4 v7, s[8:11], s95 offen offset:3072 nt lds
L_nk_1:
  s_nop 6
  v_cndmask_b32 v24, v16, v24, s[56:57]
  v_cndmask_b32 v25, v16, v25, s[58:59]
  v_cndmask_b32 v26, v16, v26, s[60:61]
  v_cndmask_b32 v27, v16, v27, s[62:63]
  v_max3_f32 v2, v24, v25, v26
  v_max3_f32 v2, v2, v27, v17
  v_mov_b32 v3, v2
  s_nop 1
  v_permlane32_swap_b32 v2, v3
  v_max_f32 v2, v2, v3
  v_mov_b32 v3, v2
  s_nop 1
  v_permlane16_swap_b32 v2, v3
  v_max_f32 v2, v2, v3
  v_sub_f32 v3, v17, v2
  v_mul_f32 v21, s36, v2
  v_mul_f32 v3, s36, v3
  v_mov_b32 v17, v2
  v_exp_f32 v23, v3
  v_fma_f32 v24, v24, s36, -v21
  v_fma_f32 v25, v25, s36, -v21
  v_fma_f32 v26, v26, s36, -v21
  v_fma_f32 v27, v27, s36, -v21
  v_exp_f32 v24, v24
  v_exp_f32 v25, v25
  v_exp_f32 v26, v26
  v_exp_f32 v27, v27
  v_cmp_neq_f32 vcc, 1.0, v23
  v_add_f32 v2, v24, v25
  v_add_f32 v3, v26, v27
  v_cvt_pk_bf16_f32 v28, v24, v25
  v_cvt_pk_bf16_f32 v29, v26, v27
  v_add_f32 v2, v2, v3
  v_fma_f32 v18, v18, v23, v2
  s_cbranch_vccz L_nors_1
  v_pk_mul_f32 v[96:97], v[22:23], v[96:97] op_sel:[1,0] op_sel_hi:[1,1]
  v_pk_mul_f32 v[98:99], v[22:23], v[98:99] op_sel:[1,0] op_sel_hi:[1,1]
  v_pk_mul_f32 v[100:101], v[22:23], v[100:101] op_sel:[1,0] op_sel_hi:[1,1]
  v_pk_mul_f32 v[102:103], v[22:23], v[102:103] op_sel:[1,0] op_sel_hi:[1,1]
  v_pk_mul_f32 v[104:105], v[22:23], v[104:105] op_sel:[1,0] op_sel_hi:[1,1]
  v_pk_mul_f32 v[106:107], v[22:23], v[106:107] op_sel:[1,0] op_sel_hi:[1,1]
  v_pk_mul_f32 v[108:109], v[22:23], v[108:109] op_sel:[1,0] op_sel_hi:[1,1]
  v_pk_mul_f32 v[110:111], v[22:23], v[110:111] op_sel:[1,0] op_sel_hi:[1,1]
  v_pk_mul_f32 v[112:113], v[22:23], v[112:113] op_sel:[1,0] op_sel_hi:[1,1]
  v_pk_mul_f32 v[114:115], v[22:23], v[114:115] op_sel:[1,0] op_sel_hi:[1,1]
  v_pk_mul_f32 v[116:117], v[22:23], v[116:117] op_sel:[1,0] op_sel_hi:[1,1]
  v_pk_mul_f32 v[118:119], v[22:23], v[118:119] op_sel:[1,0] op_sel_hi:[1,1]
  v_pk_mul_f32 v[120:121], v[22:23], v[120:121] op_sel:[1,0] op_sel_hi:[1,1]
  v_pk_mul_f32 v[122:123], v[22:23], v[122:123] op_sel:[1,0] op_sel_hi:[1,1]
  v_pk_mul_f32 v[124:125], v[22:23], v[124:125] op_sel:[1,0] op_sel_hi:[1,1]
  v_pk_mul_f32 v[126:127], v[22:23], v[126:127] op_sel:[1,0] op_sel_hi:[1,1]
L_nors_1:
  s_cmp_gt_u32 s94, 2
  s_cbranch_scc1 L_v12_1
  s_cmp_eq_u32 s94, 2
  s_cbranch_scc1 L_v8_1
  s_waitcnt vmcnt(0)
L_v8_1:
  s_waitcnt vmcnt(8)
L_v12_1:
  s_waitcnt vmcnt(12)
  s_cmp_le_u32 s94, 2
  v_perm_b32 v48, v84, v80, s37
L_wreg_2:
L_pad_5:
  s_cbranch_execz L_pad_6
  v_perm_b32 v49, v92, v88, s37
  v_perm_b32 v50, v84, v80, s38
  v_perm_b32 v51, v92, v88, s38
  v_perm_b32 v52, v85, v81, s37
  v_perm_b32 v53, v93, v89, s37
  v_perm_b32 v54, v85, v81, s38
  v_perm_b32 v55, v93, v89, s38
  v_perm_b32 v56, v86, v82, s37
  v_perm_b32 v57, v94, v90, s37
  v_perm_b32 v58, v86, v82, s38
  v_perm_b32 v59, v94, v90, s38
  v_perm_b32 v60, v87, v83, s37
  v_perm_b32 v61, v95, v91, s37
  v_perm_b32 v62, v87, v83, s38
  v_perm_b32 v63, v95, v91, s38
  s_cbranch_scc1 L_nv_1
  buffer_load_dwordx4 v[80:83], v8, s[12:15], s95 offen offset:0 nt
  buffer_load_dwordx4 v[84:87], v8, s[12:15], s95 offen offset:2048 nt
  buffer_load_dwordx4 v[88:91], v9, s[12:15], s95 offen offset:0 nt
  buffer_load_dwordx4 v[92:95], v9, s[12:15], s95 offen offset:2048 nt
L_nv_1:
  s_add_u32 s93, s93, 1
  v_mfma_f32_16x16x16_bf16 v[96:99], v[48:49], v[28:29], v[96:99]
  v_mfma_f32_16x16x16_bf16 v[100:103], v[50:51], v[28:29], v[100:103]
  v_mfma_f32_16x16x16_bf16 v[104:107], v[52:53], v[28:29], v[104:107]
  v_mfma_f32_16x16x16_bf16 v[108:111], v[54:55], v[28:29], v[108:111]
  v_mfma_f32_16x16x16_bf16 v[112:115], v[56:57], v[28:29], v[112:115]
  v_mfma_f32_16x16x16_bf16 v[116:119], v[58:59], v[28:29], v[116:119]
  v_mfma_f32_16x16x16_bf16 v[120:123], v[60:61], v[28:29], v[120:123]
  v_mfma_f32_16x16x16_bf16 v[124:127], v[62:63], v[28:29], v[124:127]
  s_sub_u32 s94, s94, 1
  s_cmp_eq_u32 s94, 0
  s_cbranch_scc0 L_loop
L_done:
  v_mov_b32 v3, v18
  v_mov_b32 v24, v17
  s_nop 0
  v_permlane32_swap_b32 v18, v3
  v_add_f32 v18, v18, v3
  v_mov_b32 v3, v18
  s_bitcmp1_b32 s97, s5
  s_nop 0
  v_permlane16_swap_b32 v18, v3
  v_add_f32 v25, v18, v3
  ds_write_b64 v129, v[24:25] offset:0
  ds_write_b128 v128, v[96:99]
  v_xor_b32 v2, 16, v128
  ds_write_b128 v2, v[100:103]
  v_xor_b32 v3, 32, v128
  ds_write_b128 v3, v[104:107]
  v_xor_b32 v2, 48, v128
  ds_write_b128 v2, v[108:111]
  v_xor_b32 v3, 64, v128
  ds_write_b128 v3, v[112:115]
  v_xor_b32 v2, 80, v128
  ds_write_b128 v2, v[116:119]
  v_xor_b32 v3, 96, v128
  ds_write_b128 v3, v[120:123]
  v_xor_b32 v2, 112, v128
  ds_write_b128 v2, v[124:127]
  s_waitcnt lgkmcnt(0)
  s_barrier
L_red:
  s_cbranch_scc0 L_fin
  ds_read_b128 v[32:35], v131 offset:0
  ds_read_b128 v[36:39], v131 offset:16
  ds_read_b128 v[64:67], v130 offset:12544
  ds_read_b128 v[68:71], v130 offset:12800
  ds_read_b128 v[72:75], v130 offset:28928
  ds_read_b128 v[76:79], v130 offset:29184
  ds_read_b128 v[80:83], v130 offset:45312
  ds_read_b128 v[84:87], v130 offset:45568
  ds_read_b128 v[88:91], v130 offset:61696
  ds_read_b128 v[92:95], v130 offset:61952
  s_waitcnt lgkmcnt(8)
  v_max3_f32 v136, v32, v34, v36
  v_max_f32 v136, v136, v38
  v_sub_f32 v40, v32, v136
  v_sub_f32 v42, v34, v136
L_pad_6:
  s_cbranch_execz L_wret
  v_sub_f32 v44, v36, v136
  v_sub_f32 v46, v38, v136
  v_mul_f32 v40, s36, v40
  v_mul_f32 v42, s36, v42
  v_mul_f32 v44, s36, v44
  v_mul_f32 v46, s36, v46
  v_exp_f32 v40, v40
  v_exp_f32 v42, v42
  v_exp_f32 v44, v44
  v_exp_f32 v46, v46
  s_waitcnt lgkmcnt(6)
  v_mul_f32 v137, v40, v33
  v_pk_mul_f32 v[96:97], v[40:41], v[64:65] op_sel_hi:[0,1]
  v_pk_mul_f32 v[98:99], v[40:41], v[66:67] op_sel_hi:[0,1]
  v_pk_mul_f32 v[100:101], v[40:41], v[68:69] op_sel_hi:[0,1]
  v_pk_mul_f32 v[102:103], v[40:41], v[70:71] op_sel_hi:[0,1]
  v_fmac_f32 v137, v42, v35
  s_waitcnt lgkmcnt(4)
  v_pk_fma_f32 v[96:97], v[42:43], v[72:73], v[96:97] op_sel_hi:[0,1,1]
  v_pk_fma_f32 v[98:99], v[42:43], v[74:75], v[98:99] op_sel_hi:[0,1,1]
  v_pk_fma_f32 v[100:101], v[42:43], v[76:77], v[100:101] op_sel_hi:[0,1,1]
  v_pk_fma_f32 v[102:103], v[42:43], v[78:79], v[102:103] op_sel_hi:[0,1,1]
  v_fmac_f32 v137, v44, v37
  s_waitcnt lgkmcnt(2)
  v_pk_fma_f32 v[96:97], v[44:45], v[80:81], v[96:97] op_sel_hi:[0,1,1]
  v_pk_fma_f32 v[98:99], v[44:45], v[82:83], v[98:99] op_sel_hi:[0,1,1]
  v_pk_fma_f32 v[100:101], v[44:45], v[84:85], v[100:101] op_sel_hi:[0,1,1]
  v_pk_fma_f32 v[102:103], v[44:45], v[86:87], v[102:103] op_sel_hi:[0,1,1]
  v_fmac_f32 v137, v46, v39
  s_waitcnt lgkmcnt(0)
  v_pk_fma_f32 v[96:97], v[46:47], v[88:89], v[96:97] op_sel_hi:[0,1,1]
  v_bfi_b32 v96, v134, s72, v96
  v_bfi_b32 v97, v134, s73, v97
  v_pk_fma_f32 v[98:99], v[46:47], v[90:91], v[98:99] op_sel_hi:[0,1,1]
  v_bfi_b32 v98, v134, s74, v98
  v_bfi_b32 v99, v134, s75, v99
  global_store_dwordx4 v132, v[96:99], s[30:31] sc1
  v_pk_fma_f32 v[100:101], v[46:47], v[92:93], v[100:101] op_sel_hi:[0,1,1]
  v_bfi_b32 v100, v134, s72, v100
  v_bfi_b32 v101, v134, s73, v101
  v_pk_fma_f32 v[102:103], v[46:47], v[94:95], v[102:103] op_sel_hi:[0,1,1]
  v_bfi_b32 v102, v134, s74, v102
  v_bfi_b32 v103, v134, s75, v103
  global_store_dwordx4 v132, v[100:103], s[30:31] offset:384 sc1
  global_store_dwordx4 v133, v[136:139], s[30:31] offset:256 sc1
  s_mov_b64 exec, -1
L_fin:
L_fin3:
  s_cmp_lg_u32 s3, 7
  s_cbranch_scc1 L_end
  s_lshl_b32 s93, s7, 13
  s_lshl_b32 s64, s6, 7
  s_add_u32 s93, s93, s64
  s_add_u32 s93, s93, 4096
  v_lshl_add_u32 v2, v1, 3, s93
  s_mov_b64 exec, 0xffff
  global_store_dwordx2 v2, v[138:139], s[30:31] sc1
L_fin2:
  s_endpgm
L_helper:
  s_setprio 3
  s_sub_u32 s4, s3, 8
  s_lshl_b32 s93, s4, 10
  s_add_u32 s93, s93, 0x1000
  v_lshl_add_u32 v2, v1, 4, s93
  v_add_u32 v3, 0x2000, v2
  s_waitcnt lgkmcnt(0)
  global_load_dwordx4 v[32:35], v2, s[22:23] offset:-4096
  global_load_dwordx4 v[36:39], v2, s[22:23]
  global_load_dwordx4 v[40:43], v3, s[22:23] offset:-4096
  global_load_dwordx4 v[44:47], v3, s[22:23]
  s_load_dwordx4 s[32:35], s[24:25], 0
  s_load_dword s76, s[30:31], s76
  s_mov_b64 exec, 0
  s_cmp_eq_u32 s3, 8
  s_cbranch_scc1 L_wreg_4
  s_cmp_eq_u32 s3, 9
  s_cbranch_scc1 L_wreg_5
  s_cmp_eq_u32 s3, 10
  s_cbranch_scc1 L_wreg_6
  s_branch L_wreg_7
L_wreth:
  s_mov_b64 exec, -1
  v_lshlrev_b32 v4, 2, v1
  v_add_u32 v5, 1, v4
  v_add_u32 v6, 2, v4
  v_add_u32 v7, 3, v4
  s_lshl_b32 s93, s4, 12
  v_lshl_add_u32 v13, v1, 6, s93
  s_lshl_b32 s93, s4, 3
L_wreg_3:
L_pad_7:
  s_cbranch_execz L_pad_8
  v_lshl_add_u32 v11, v1, 5, s93
  v_lshlrev_b32 v10, 3, v1
  v_mov_b32 v31, 1
  v_mov_b32 v8, 0
  v_mov_b32 v9, 0
  v_and_b32 v2, 3, v1
  v_cmp_eq_u32 s[20:21], s4, v2
  s_lshl_b32 s92, s4, 8
  s_waitcnt lgkmcnt(0)
  s_cmp_lt_i32 s32, 1
  s_cselect_b32 s32, 0x4000, s32
  s_min_i32 s32, s32, 0x4000
  s_add_u32 s36, s32, 15
  s_lshr_b32 s36, s36, 4
  s_sub_i32 s36, s36, s92
  s_max_i32 s36, s36, 0
  s_min_i32 s36, s36, 256
  s_cmp_lt_i32 s33, 1
  s_cselect_b32 s33, 0x4000, s33
  s_min_i32 s33, s33, 0x4000
  s_add_u32 s37, s33, 15
  s_lshr_b32 s37, s37, 4
  s_sub_i32 s37, s37, s92
  s_max_i32 s37, s37, 0
  s_min_i32 s37, s37, 256
  s_cmp_lt_i32 s34, 1
  s_cselect_b32 s34, 0x4000, s34
  s_min_i32 s34, s34, 0x4000
  s_add_u32 s38, s34, 15
  s_lshr_b32 s38, s38, 4
  s_sub_i32 s38, s38, s92
  s_max_i32 s38, s38, 0
  s_min_i32 s38, s38, 256
  s_cmp_lt_i32 s35, 1
  s_cselect_b32 s35, 0x4000, s35
  s_min_i32 s35, s35, 0x4000
  s_add_u32 s39, s35, 15
  s_lshr_b32 s39, s39, 4
  s_sub_i32 s39, s39, s92
  s_max_i32 s39, s39, 0
  s_min_i32 s39, s39, 256
  s_waitcnt vmcnt(0)
  v_add_u32 v3, 2560, v32
  v_min_u32 v32, v32, v3
  v_add_u32 v2, 2560, v33
  v_min_u32 v33, v33, v2
  v_add_u32 v3, 2560, v34
  v_min_u32 v34, v34, v3
  v_add_u32 v2, 2560, v35
  v_min_u32 v35, v35, v2
  v_add_u32 v3, 2560, v36
  v_min_u32 v36, v36, v3
  v_add_u32 v2, 2560, v37
  v_min_u32 v37, v37, v2
  v_add_u32 v3, 2560, v38
  v_min_u32 v38, v38, v3
  v_add_u32 v2, 2560, v39
  v_min_u32 v39, v39, v2
  v_add_u32 v3, 2560, v40
  v_min_u32 v40, v40, v3
  v_add_u32 v2, 2560, v41
  v_min_u32 v41, v41, v2
  v_add_u32 v3, 2560, v42
  v_min_u32 v42, v42, v3
  v_add_u32 v2, 2560, v43
  v_min_u32 v43, v43, v2
  v_add_u32 v3, 2560, v44
  v_min_u32 v44, v44, v3
  v_add_u32 v2, 2560, v45
  v_min_u32 v45, v45, v2
  v_add_u32 v3, 2560, v46
  v_min_u32 v46, v46, v3
  v_add_u32 v2, 2560, v47
  v_min_u32 v47, v47, v2
  s_cmp_eq_u32 s36, 256
  s_cbranch_scc1 L_full_0
  v_cmp_gt_u32 s[52:53], s36, v4
  v_cmp_gt_u32 s[54:55], s36, v5
  v_cmp_gt_u32 s[56:57], s36, v6
  v_cmp_gt_u32 s[58:59], s36, v7
  v_cndmask_b32 v32, -1, v32, s[52:53]
  v_cndmask_b32 v33, -1, v33, s[54:55]
  v_cndmask_b32 v34, -1, v34, s[56:57]
  v_cndmask_b32 v35, -1, v35, s[58:59]
L_full_0:
  s_cmp_eq_u32 s37, 256
  s_cbranch_scc1 L_full_1
L_pad_8:
  s_cbranch_execz L_wret
  v_cmp_gt_u32 s[52:53], s37, v4
  v_cmp_gt_u32 s[54:55], s37, v5
  v_cmp_gt_u32 s[56:57], s37, v6
  v_cmp_gt_u32 s[58:59], s37, v7
  v_cndmask_b32 v36, -2, v36, s[52:53]
  v_cndmask_b32 v37, -2, v37, s[54:55]
  v_cndmask_b32 v38, -2, v38, s[56:57]
  v_cndmask_b32 v39, -2, v39, s[58:59]
L_full_1:
  s_cmp_eq_u32 s38, 256
  s_cbranch_scc1 L_full_2
  v_cmp_gt_u32 s[52:53], s38, v4
  v_cmp_gt_u32 s[54:55], s38, v5
  v_cmp_gt_u32 s[56:57], s38, v6
  v_cmp_gt_u32 s[58:59], s38, v7
  v_cndmask_b32 v40, -3, v40, s[52:53]
  v_cndmask_b32 v41, -3, v41, s[54:55]
  v_cndmask_b32 v42, -3, v42, s[56:57]
  v_cndmask_b32 v43, -3, v43, s[58:59]
L_full_2:
  s_cmp_eq_u32 s39, 256
  s_cbranch_scc1 L_full_3
  v_cmp_gt_u32 s[52:53], s39, v4
  v_cmp_gt_u32 s[54:55], s39, v5
  v_cmp_gt_u32 s[56:57], s39, v6
  v_cmp_gt_u32 s[58:59], s39, v7
  v_cndmask_b32 v44, -4, v44, s[52:53]
  v_cndmask_b32 v45, -4, v45, s[54:55]
  v_cndmask_b32 v46, -4, v46, s[56:57]
  v_cndmask_b32 v47, -4, v47, s[58:59]
L_full_3:
  v_cmp_eq_u32 s[40:41], v32, v36
  v_cmp_eq_u32 s[42:43], v32, v40
  v_cmp_eq_u32 s[44:45], v36, v40
  v_cmp_eq_u32 s[46:47], v32, v44
  v_cmp_eq_u32 s[48:49], v36, v44
  v_cmp_eq_u32 s[50:51], v40, v44
  v_cmp_eq_u32 s[52:53], v33, v37
  v_cmp_eq_u32 s[54:55], v33, v41
  v_cmp_eq_u32 s[56:57], v37, v41
  v_cmp_eq_u32 s[58:59], v33, v45
  v_cmp_eq_u32 s[60:61], v37, v45
  v_cmp_eq_u32 s[62:63], v41, v45
  s_mov_b64 s[8:9], s[40:41]
  s_mov_b64 s[10:11], s[42:43]
  s_mov_b64 s[12:13], s[44:45]
  s_mov_b64 s[14:15], s[46:47]
  s_mov_b64 s[16:17], s[48:49]
  s_mov_b64 s[18:19], s[50:51]
  s_bcnt1_i32_b64 s93, s[40:41]
  s_or_b64 s[42:43], s[42:43], s[44:45]
  s_sub_u32 s37, s37, s93
  s_bcnt1_i32_b64 s93, s[42:43]
  s_or_b64 s[46:47], s[46:47], s[48:49]
  s_sub_u32 s38, s38, s93
  s_or_b64 s[46:47], s[46:47], s[50:51]
  s_bcnt1_i32_b64 s93, s[46:47]
  s_sub_u32 s39, s39, s93
  v_cmp_eq_u32 s[40:41], v34, v38
  v_cmp_eq_u32 s[42:43], v34, v42
  v_cmp_eq_u32 s[44:45], v38, v42
  v_cmp_eq_u32 s[46:47], v34, v46
  v_cmp_eq_u32 s[48:49], v38, v46
  v_cmp_eq_u32 s[50:51], v42, v46
  s_or_b64 s[8:9], s[8:9], s[52:53]
  s_or_b64 s[10:11], s[10:11], s[54:55]
  s_or_b64 s[12:13], s[12:13], s[56:57]
  s_or_b64 s[14:15], s[14:15], s[58:59]
  s_or_b64 s[16:17], s[16:17], s[60:61]
  s_or_b64 s[18:19], s[18:19], s[62:63]
  s_bcnt1_i32_b64 s93, s[52:53]
  s_or_b64 s[54:55], s[54:55], s[56:57]
  s_sub_u32 s37, s37, s93
  s_bcnt1_i32_b64 s93, s[54:55]
  s_or_b64 s[58:59], s[58:59], s[60:61]
  s_sub_u32 s38, s38, s93
  s_or_b64 s[58:59], s[58:59], s[62:63]
  s_bcnt1_i32_b64 s93, s[58:59]
  s_sub_u32 s39, s39, s93
  v_cmp_eq_u32 s[52:53], v35, v39
  v_cmp_eq_u32 s[54:55], v35, v43
  v_cmp_eq_u32 s[56:57], v39, v43
L_wreg_4:
L_pad_9:
  s_cbranch_execz L_pad_10
  v_cmp_eq_u32 s[58:59], v35, v47
  v_cmp_eq_u32 s[60:61], v39, v47
  v_cmp_eq_u32 s[62:63], v43, v47
  s_or_b64 s[8:9], s[8:9], s[40:41]
  s_or_b64 s[10:11], s[10:11], s[42:43]
  s_or_b64 s[12:13], s[12:13], s[44:45]
  s_or_b64 s[14:15], s[14:15], s[46:47]
  s_or_b64 s[16:17], s[16:17], s[48:49]
  s_or_b64 s[18:19], s[18:19], s[50:51]
  s_bcnt1_i32_b64 s93, s[40:41]
  s_or_b64 s[42:43], s[42:43], s[44:45]
  s_sub_u32 s37, s37, s93
  s_bcnt1_i32_b64 s93, s[42:43]
  s_or_b64 s[46:47], s[46:47], s[48:49]
  s_sub_u32 s38, s38, s93
  s_or_b64 s[46:47], s[46:47], s[50:51]
  s_bcnt1_i32_b64 s93, s[46:47]
  s_sub_u32 s39, s39, s93
  s_or_b64 s[8:9], s[8:9], s[52:53]
  s_or_b64 s[10:11], s[10:11], s[54:55]
  s_or_b64 s[12:13], s[12:13], s[56:57]
  s_or_b64 s[14:15], s[14:15], s[58:59]
  s_or_b64 s[16:17], s[16:17], s[60:61]
  s_or_b64 s[18:19], s[18:19], s[62:63]
  s_bcnt1_i32_b64 s93, s[52:53]
  s_or_b64 s[54:55], s[54:55], s[56:57]
  s_sub_u32 s37, s37, s93
  s_bcnt1_i32_b64 s93, s[54:55]
  s_or_b64 s[58:59], s[58:59], s[60:61]
  s_sub_u32 s38, s38, s93
  s_or_b64 s[58:59], s[58:59], s[62:63]
  s_bcnt1_i32_b64 s93, s[58:59]
  s_sub_u32 s39, s39, s93
  s_mov_b32 s65, 1
  s_cmp_lg_u64 s[8:9], 0
  s_cselect_b32 s93, 2, 0
  s_or_b32 s65, s65, s93
  s_cmp_lg_u64 s[10:11], 0
  s_cselect_b32 s93, 4, 0
  s_or_b32 s65, s65, s93
  s_cmp_lg_u64 s[14:15], 0
  s_cselect_b32 s93, 8, 0
  s_or_b32 s65, s65, s93
  v_writelane_b32 v28, s36, 0
  v_writelane_b32 v29, s65, 0
  s_mov_b32 s65, 2
  s_cmp_lg_u64 s[12:13], 0
  s_cselect_b32 s93, 4, 0
  s_or_b32 s65, s65, s93
  s_cmp_lg_u64 s[16:17], 0
  s_cselect_b32 s93, 8, 0
  s_or_b32 s65, s65, s93
  v_writelane_b32 v28, s37, 1
  v_writelane_b32 v29, s65, 1
  s_mov_b32 s65, 4
  s_cmp_lg_u64 s[18:19], 0
  s_cselect_b32 s93, 8, 0
  s_or_b32 s65, s65, s93
  v_writelane_b32 v28, s38, 2
  v_writelane_b32 v29, s65, 2
  s_mov_b32 s65, 8
  v_writelane_b32 v28, s39, 3
  v_writelane_b32 v29, s65, 3
  s_mov_b64 exec, 0xf
  ds_write_b64 v11, v[28:29] offset:1088
  s_mov_b64 exec, 1
  ds_add_u32 v30, v31 offset:1032
L_hsync:
  ds_read_b32 v2, v30 offset:1032
  s_waitcnt lgkmcnt(0)
  v_readfirstlane_b32 s93, v2
  s_cmp_lt_u32 s93, 4
  s_cbranch_scc1 L_hsync
  s_mov_b64 exec, 0xffff
  ds_read_b64 v[8:9], v10 offset:1088
  s_mov_b64 exec, -1
  s_waitcnt lgkmcnt(0)
  v_mov_b32 v10, v8
  s_nop 1
  v_add_u32_dpp v10, v10, v10 row_shr:1 row_mask:0xf bank_mask:0xf bound_ctrl:0
  s_nop 1
  v_add_u32_dpp v10, v10, v10 row_shr:2 row_mask:0xf bank_mask:0xf bound_ctrl:0
  s_nop 1
  v_add_u32_dpp v10, v10, v10 row_shr:4 row_mask:0xf bank_mask:0xf bound_ctrl:0
  s_nop 1
  v_add_u32_dpp v10, v10, v10 row_shr:8 row_mask:0xf bank_mask:0xf bound_ctrl:0
  v_cmp_lt_i32 s[62:63], 0, v8
  v_readlane_b32 s100, v10, 15
  v_sub_u32 v16, v10, v8
  s_mul_i32 s98, s6, s100
  s_add_u32 s99, s98, s100
  s_lshr_b32 s98, s98, 6
  s_lshr_b32 s99, s99, 6
  v_cmp_lt_u32 s[60:61], s98, v10
  v_cmp_gt_u32 vcc, s99, v16
  s_sub_u32 s99, s99, s98
  v_subrev_u32 v10, s98, v16
  s_and_b64 s[60:61], s[60:61], s[62:63]
  s_and_b64 s[60:61], s[60:61], vcc
  v_cndmask_b32 v12, 0, v9, s[60:61]
  s_and_b64 s[60:61], s[60:61], s[20:21]
  s_cbranch_scc0 L_p2done
L_p2:
  s_ff1_i32_b64 s66, s[60:61]
L_pad_10:
  s_cbranch_execz L_wreth
  s_bitset0_b64 s[60:61], s66
  s_lshr_b32 s65, s66, 2
  v_readlane_b32 s94, v10, s66
  s_cmp_lg_u32 s65, 0
  s_cbranch_scc1 L_sel_1
  v_mov_b32 v48, v32
  v_mov_b32 v49, v33
  v_mov_b32 v50, v34
  v_mov_b32 v51, v35
  s_branch L_seld
L_sel_1:
  s_cmp_lg_u32 s65, 1
  s_cbranch_scc1 L_sel_2
  v_mov_b32 v48, v36
  v_mov_b32 v49, v37
  v_mov_b32 v50, v38
  v_mov_b32 v51, v39
  s_branch L_seld
L_sel_2:
  s_cmp_lg_u32 s65, 2
  s_cbranch_scc1 L_sel_3
  v_mov_b32 v48, v40
  v_mov_b32 v49, v41
  v_mov_b32 v50, v42
  v_mov_b32 v51, v43
  s_branch L_seld
L_sel_3:
  v_mov_b32 v48, v44
  v_mov_b32 v49, v45
  v_mov_b32 v50, v46
  v_mov_b32 v51, v47
L_seld:
  s_lshl_b32 s93, s65, 3
  s_lshl_b32 s68, 0xff, s93
  s_lshl_b32 s67, 1, s93
  s_sub_u32 s67, s67, 1
  v_mov_b32 v14, v13
  v_mov_b32 v11, s94
  v_cmp_eq_u32 s[40:41], v48, v32
  v_cmp_eq_u32 s[42:43], v48, v36
  v_cmp_eq_u32 s[44:45], v48, v40
  v_cmp_eq_u32 s[46:47], v48, v44
  v_sub_u32 v52, s32, v14
  v_med3_i32 v52, v52, 0, 16
  v_cndmask_b32 v52, 0, v52, s[40:41]
  v_sub_u32 v15, s33, v14
  v_med3_i32 v15, v15, 0, 16
  v_cndmask_b32 v15, 0, v15, s[42:43]
  v_lshl_or_b32 v52, v15, 8, v52
  v_sub_u32 v15, s34, v14
  v_med3_i32 v15, v15, 0, 16
  v_cndmask_b32 v15, 0, v15, s[44:45]
  v_lshl_or_b32 v52, v15, 16, v52
  v_sub_u32 v15, s35, v14
  v_med3_i32 v15, v15, 0, 16
  v_cndmask_b32 v15, 0, v15, s[46:47]
  v_lshl_or_b32 v52, v15, 24, v52
  v_and_b32 v2, s67, v52
  v_and_b32 v3, s68, v52
  v_cmp_eq_u32 s[52:53], 0, v2
  v_cmp_ne_u32 s[62:63], 0, v3
  s_and_b64 s[52:53], s[52:53], s[62:63]
  v_mbcnt_lo_u32_b32 v11, s52, v11
  v_mbcnt_hi_u32_b32 v11, s53, v11
  v_add_u32 v14, 16, v14
  v_cmp_eq_u32 s[40:41], v49, v33
  v_cmp_eq_u32 s[42:43], v49, v37
  v_cmp_eq_u32 s[44:45], v49, v41
  v_cmp_eq_u32 s[46:47], v49, v45
  v_sub_u32 v53, s32, v14
  v_med3_i32 v53, v53, 0, 16
  v_cndmask_b32 v53, 0, v53, s[40:41]
  v_sub_u32 v15, s33, v14
  v_med3_i32 v15, v15, 0, 16
  v_cndmask_b32 v15, 0, v15, s[42:43]
  v_lshl_or_b32 v53, v15, 8, v53
  v_sub_u32 v15, s34, v14
  v_med3_i32 v15, v15, 0, 16
  v_cndmask_b32 v15, 0, v15, s[44:45]
  v_lshl_or_b32 v53, v15, 16, v53
  v_sub_u32 v15, s35, v14
  v_med3_i32 v15, v15, 0, 16
  v_cndmask_b32 v15, 0, v15, s[46:47]
  v_lshl_or_b32 v53, v15, 24, v53
  v_and_b32 v2, s67, v53
  v_and_b32 v3, s68, v53
  v_cmp_eq_u32 s[54:55], 0, v2
  v_cmp_ne_u32 s[62:63], 0, v3
  s_and_b64 s[54:55], s[54:55], s[62:63]
  v_mbcnt_lo_u32_b32 v11, s54, v11
L_wreg_5:
L_pad_11:
  s_cbranch_execz L_pad_12
  v_mbcnt_hi_u32_b32 v11, s55, v11
  v_add_u32 v14, 16, v14
  v_cmp_eq_u32 s[40:41], v50, v34
  v_cmp_eq_u32 s[42:43], v50, v38
  v_cmp_eq_u32 s[44:45], v50, v42
  v_cmp_eq_u32 s[46:47], v50, v46
  v_sub_u32 v54, s32, v14
  v_med3_i32 v54, v54, 0, 16
  v_cndmask_b32 v54, 0, v54, s[40:41]
  v_sub_u32 v15, s33, v14
  v_med3_i32 v15, v15, 0, 16
  v_cndmask_b32 v15, 0, v15, s[42:43]
  v_lshl_or_b32 v54, v15, 8, v54
  v_sub_u32 v15, s34, v14
  v_med3_i32 v15, v15, 0, 16
  v_cndmask_b32 v15, 0, v15, s[44:45]
  v_lshl_or_b32 v54, v15, 16, v54
  v_sub_u32 v15, s35, v14
  v_med3_i32 v15, v15, 0, 16
  v_cndmask_b32 v15, 0, v15, s[46:47]
  v_lshl_or_b32 v54, v15, 24, v54
  v_and_b32 v2, s67, v54
  v_and_b32 v3, s68, v54
  v_cmp_eq_u32 s[56:57], 0, v2
  v_cmp_ne_u32 s[62:63], 0, v3
  s_and_b64 s[56:57], s[56:57], s[62:63]
  v_mbcnt_lo_u32_b32 v11, s56, v11
  v_mbcnt_hi_u32_b32 v11, s57, v11
  v_add_u32 v14, 16, v14
  v_cmp_eq_u32 s[40:41], v51, v35
  v_cmp_eq_u32 s[42:43], v51, v39
  v_cmp_eq_u32 s[44:45], v51, v43
  v_cmp_eq_u32 s[46:47], v51, v47
  v_sub_u32 v55, s32, v14
  v_med3_i32 v55, v55, 0, 16
  v_cndmask_b32 v55, 0, v55, s[40:41]
  v_sub_u32 v15, s33, v14
  v_med3_i32 v15, v15, 0, 16
  v_cndmask_b32 v15, 0, v15, s[42:43]
  v_lshl_or_b32 v55, v15, 8, v55
  v_sub_u32 v15, s34, v14
  v_med3_i32 v15, v15, 0, 16
  v_cndmask_b32 v15, 0, v15, s[44:45]
  v_lshl_or_b32 v55, v15, 16, v55
  v_sub_u32 v15, s35, v14
  v_med3_i32 v15, v15, 0, 16
  v_cndmask_b32 v15, 0, v15, s[46:47]
  v_lshl_or_b32 v55, v15, 24, v55
  v_and_b32 v2, s67, v55
  v_and_b32 v3, s68, v55
  v_cmp_eq_u32 s[58:59], 0, v2
  v_cmp_ne_u32 s[62:63], 0, v3
  s_and_b64 s[58:59], s[58:59], s[62:63]
  v_mbcnt_lo_u32_b32 v11, s58, v11
  v_mbcnt_hi_u32_b32 v11, s59, v11
  v_cmp_gt_u32 vcc, s99, v11
  v_lshlrev_b32 v2, 3, v11
  v_add_u32 v2, 1280, v2
  s_and_b64 exec, vcc, s[52:53]
  ds_write2_b32 v2, v48, v52 offset0:0 offset1:1
  s_mov_b64 exec, -1
  v_addc_co_u32 v11, vcc, 0, v11, s[52:53]
  v_cmp_gt_u32 vcc, s99, v11
  v_lshlrev_b32 v2, 3, v11
  v_add_u32 v2, 1280, v2
  s_and_b64 exec, vcc, s[54:55]
  ds_write2_b32 v2, v49, v53 offset0:0 offset1:1
  s_mov_b64 exec, -1
  v_addc_co_u32 v11, vcc, 0, v11, s[54:55]
  v_cmp_gt_u32 vcc, s99, v11
  v_lshlrev_b32 v2, 3, v11
  v_add_u32 v2, 1280, v2
  s_and_b64 exec, vcc, s[56:57]
  ds_write2_b32 v2, v50, v54 offset0:0 offset1:1
  s_mov_b64 exec, -1
  v_addc_co_u32 v11, vcc, 0, v11, s[56:57]
  v_cmp_gt_u32 vcc, s99, v11
  v_lshlrev_b32 v2, 3, v11
L_pad_12:
  s_cbranch_execz L_wreth
  v_add_u32 v2, 1280, v2
  s_and_b64 exec, vcc, s[58:59]
  ds_write2_b32 v2, v51, v55 offset0:0 offset1:1
  s_mov_b64 exec, -1
  s_cmp_lg_u64 s[60:61], 0
  s_cbranch_scc1 L_p2
L_p2done:
  s_cmp_lg_u32 s4, 3
  s_cbranch_scc1 L_nohdr
  s_mov_b32 s97, 0
  v_and_b32 v2, 1, v12
  v_cmp_ne_u32 vcc, 0, v2
  s_cmp_lg_u64 vcc, 0
  s_cselect_b32 s93, 1, 0
  s_or_b32 s97, s97, s93
  v_and_b32 v2, 2, v12
  v_cmp_ne_u32 vcc, 0, v2
  s_cmp_lg_u64 vcc, 0
  s_cselect_b32 s93, 2, 0
  s_or_b32 s97, s97, s93
  v_and_b32 v2, 4, v12
  v_cmp_ne_u32 vcc, 0, v2
  s_cmp_lg_u64 vcc, 0
  s_cselect_b32 s93, 4, 0
  s_or_b32 s97, s97, s93
  v_and_b32 v2, 8, v12
  v_cmp_ne_u32 vcc, 0, v2
  s_cmp_lg_u64 vcc, 0
  s_cselect_b32 s93, 8, 0
  s_or_b32 s97, s97, s93
  v_mov_b32 v28, s99
  v_mov_b32 v29, s97
  ds_write_b64 v30, v[28:29] offset:1024
L_nohdr:
  s_waitcnt lgkmcnt(0)
  s_barrier
  s_and_b32 s72, s76, 0xff
  s_add_u32 s72, s72, 1
  s_cmp_eq_u32 s72, 0x100
  s_cselect_b32 s72, 1, s72
  s_bfe_u32 s73, s76, 0x80008
  s_max_u32 s73, s73, 1
  s_bfe_u32 s74, s76, 0x80010
  s_max_u32 s74, s74, 1
  s_lshr_b32 s75, s76, 24
  s_max_u32 s75, s75, 1
  s_xor_b32 s70, s76, 0x9e3779b9
  s_mul_i32 s71, s76, 0x85ebca6b
  s_add_u32 s71, s71, 0x6a09e667
  s_lshl_b32 s93, s7, 5
  s_lshr_b32 s94, s6, 1
  s_add_u32 s93, s93, s94
  s_mul_i32 s93, s93, 50432
  s_and_b32 s92, s6, 1
  s_mul_i32 s92, s92, 384
  s_add_u32 s93, s93, s92
  s_add_u32 s11, s93, 64768
  s_bfe_u32 s65, s94, 0x20002
  s_lshl_b32 s95, s65, 5
  s_lshl_b32 s92, s7, 3
  s_add_u32 s95, s95, s92
  s_lshr_b32 s92, s94, 4
  s_lshl_b32 s92, s92, 2
  s_add_u32 s95, s95, s92
  s_and_b32 s92, s94, 3
  s_add_u32 s95, s95, s92
  s_lshl_b32 s95, s95, 8
  s_and_b32 s92, s6, 1
  s_lshl_b32 s92, s92, 7
  s_add_u32 s95, s95, s92
  v_bfe_u32 v54, v1, 3, 1
  v_lshlrev_b32 v54, 6, v54
  v_and_b32 v3, 7, v1
  v_lshl_add_u32 v54, v3, 1, v54
  v_bfe_u32 v3, v1, 5, 1
  v_lshl_add_u32 v54, v3, 4, v54
  v_bfe_u32 v3, v1, 4, 1
  v_lshl_add_u32 v54, v3, 5, v54
  v_add_u32 v54, s95, v54
  s_mov_b32 s8, 0x3e0293ee
  s_mov_b32 s14, 0xffffff00
  s_lshl_b32 s93, s7, 13
  s_add_u32 s93, s93, 4096
  v_lshl_add_u32 v69, v1, 7, s93
  s_lshl_b32 s93, s4, 8
  v_lshl_add_u32 v72, v1, 2, s93
  s_lshl_b32 s93, s4, 3
  v_mov_b32 v73, s93
  ds_write_b32 v72, v30 offset:2304
  v_mul_lo_u32 v61, v1, s100
  v_add_u32 v62, s100, v61
  v_lshrrev_b32 v61, 6, v61
  v_lshrrev_b32 v62, 6, v62
  v_lshrrev_b32 v2, s65, v9
  v_and_b32 v2, 1, v2
  v_cmp_eq_u32 s[60:61], 1, v2
  v_cmp_lt_i32 vcc, 0, v8
  s_and_b64 s[60:61], s[60:61], vcc
  s_mov_b64 s[46:47], 0
L_need:
  s_ff1_i32_b64 s66, s[60:61]
L_wreg_6:
L_pad_13:
  s_cbranch_execz L_pad_14
  s_bitset0_b64 s[60:61], s66
  v_readlane_b32 s93, v16, s66
  v_readlane_b32 s92, v8, s66
  s_nop 0
  s_add_u32 s92, s92, s93
  v_cmp_lt_u32 vcc, s93, v62
  v_cmp_gt_u32 s[48:49], s92, v61
  s_and_b64 vcc, vcc, s[48:49]
  s_or_b64 s[46:47], s[46:47], vcc
  s_cmp_lg_u64 s[60:61], 0
  s_cbranch_scc1 L_need
  s_bcnt1_i32_b64 s92, s[46:47]
  v_mbcnt_lo_u32_b32 v2, s46, 0
  v_mbcnt_hi_u32_b32 v2, s47, v2
  v_and_b32 v3, 3, v2
  v_cmp_eq_u32 vcc, s4, v3
  v_bfe_u32 v3, v2, 2, 2
  v_lshrrev_b32 v2, 4, v2
  v_lshl_add_u32 v2, v3, 4, v2
  s_lshl_b32 s93, s4, 8
  v_lshl_add_u32 v2, v2, 2, s93
  v_add_u32 v3, 1, v1
  s_and_b64 exec, vcc, s[46:47]
  ds_write_b32 v2, v3 offset:2304
  s_mov_b64 exec, -1
  ds_read_b32 v60, v72 offset:2304
  s_add_u32 s10, s92, 15
  s_lshr_b32 s10, s10, 4
  v_and_b32 v21, 15, v1
  v_lshlrev_b32 v21, 4, v21
  v_add_u32 v21, s11, v21
  s_waitcnt lgkmcnt(0)
  v_max_u32 v22, 1, v60
  v_mul_u32_u24 v22, 768, v22
  v_add_u32 v52, s11, v22
  v_min_u32 v68, 1, v60
  v_mov_b32 v63, 0
  v_add_u32_dpp v48, v22, v21 row_newbcast:0 row_mask:0xf bank_mask:0xf
  v_add_u32_dpp v49, v22, v21 row_newbcast:1 row_mask:0xf bank_mask:0xf
  v_add_u32_dpp v50, v22, v21 row_newbcast:2 row_mask:0xf bank_mask:0xf
  v_add_u32_dpp v51, v22, v21 row_newbcast:3 row_mask:0xf bank_mask:0xf
  v_mov_b32 v32, 0
  v_mov_b32 v33, 0
  v_mov_b32 v34, 0
  v_mov_b32 v35, 0
  v_mov_b32 v36, 0
  v_mov_b32 v37, 0
  v_mov_b32 v38, 0
  v_mov_b32 v39, 0
  v_mov_b32 v40, 0
  v_mov_b32 v41, 0
  v_mov_b32 v42, 0
  v_mov_b32 v43, 0
  v_mov_b32 v44, 0
  v_mov_b32 v45, 0
  v_mov_b32 v46, 0
  v_mov_b32 v47, 0
  v_mov_b32_dpp v3, v68 row_newbcast:0 row_mask:0xf bank_mask:0xf
  v_lshl_or_b32 v63, v3, 0, v63
  s_mov_b64 s[36:37], 0
  v_mov_b32_dpp v2, v68 row_newbcast:1 row_mask:0xf bank_mask:0xf
  v_lshl_or_b32 v63, v2, 1, v63
  s_mov_b64 s[38:39], 0
  v_mov_b32_dpp v3, v68 row_newbcast:2 row_mask:0xf bank_mask:0xf
  v_lshl_or_b32 v63, v3, 2, v63
  s_mov_b64 s[40:41], 0
  v_mov_b32_dpp v2, v68 row_newbcast:3 row_mask:0xf bank_mask:0xf
  v_lshl_or_b32 v63, v2, 3, v63
  s_mov_b64 s[42:43], 0
  v_cmp_ne_u32 s[44:45], 0, v60
  v_mov_b32 v56, 0xf149f2ca
  v_mov_b32 v57, 0
  s_or_b32 s93, s6, s4
  s_cmp_eq_u32 s93, 0
  s_cselect_b64 s[18:19], -1, 0
  s_mov_b32 s94, 0x40000
  s_mov_b64 exec, s[44:45]
  global_load_dwordx4 v[64:67], v52, s[30:31] offset:256 sc1
  s_mov_b64 exec, s[18:19]
  global_load_dword v70, v69, s[30:31] sc1
  s_mov_b64 exec, -1
  s_barrier
L_poll:
L_pad_14:
  s_cbranch_execz L_wreth
  s_mov_b64 exec, s[44:45]
  global_load_dwordx4 v[56:59], v52, s[30:31] offset:256 sc1
  s_mov_b64 exec, s[36:37]
  global_load_dwordx4 v[32:35], v48, s[30:31] sc1
  s_mov_b64 exec, s[38:39]
  global_load_dwordx4 v[36:39], v49, s[30:31] sc1
  s_mov_b64 exec, s[40:41]
  global_load_dwordx4 v[40:43], v50, s[30:31] sc1
  s_mov_b64 exec, s[42:43]
  global_load_dwordx4 v[44:47], v51, s[30:31] sc1
  s_mov_b64 exec, s[18:19]
  global_load_dwordx2 v[70:71], v69, s[30:31] sc1
  s_mov_b64 exec, s[44:45]
  s_sub_u32 s94, s94, 1
  s_waitcnt vmcnt(5)
  v_cmp_ne_u32 s[44:45], s70, v58
  v_cmp_ne_u32 vcc, s71, v59
  s_mov_b64 exec, -1
  s_or_b64 s[44:45], s[44:45], vcc
  v_cndmask_b32 v55, 0, 1, s[44:45]
  s_nop 1
  v_mov_b32_dpp v76, v55 row_newbcast:0 row_mask:0xf bank_mask:0xf
  v_mov_b32_dpp v77, v55 row_newbcast:1 row_mask:0xf bank_mask:0xf
  v_mov_b32_dpp v78, v55 row_newbcast:2 row_mask:0xf bank_mask:0xf
  v_mov_b32_dpp v79, v55 row_newbcast:3 row_mask:0xf bank_mask:0xf
  s_mov_b64 exec, s[36:37]
  s_waitcnt vmcnt(4)
  v_msad_u8 v76, v32, s72, v76
  v_msad_u8 v76, v33, s73, v76
  v_msad_u8 v76, v34, s74, v76
  v_msad_u8 v76, v35, s75, v76
  v_cmp_eq_u32 vcc, 0, v76
  v_and_b32 v32, s14, v32
  v_and_b32 v33, s14, v33
  v_and_b32 v34, s14, v34
  v_and_b32 v35, s14, v35
  s_mov_b64 exec, vcc
  v_xor_b32 v63, 1, v63
  s_mov_b64 exec, s[38:39]
  s_waitcnt vmcnt(3)
  v_msad_u8 v77, v36, s72, v77
  v_msad_u8 v77, v37, s73, v77
  v_msad_u8 v77, v38, s74, v77
  v_msad_u8 v77, v39, s75, v77
  v_cmp_eq_u32 vcc, 0, v77
  v_and_b32 v36, s14, v36
  v_and_b32 v37, s14, v37
  v_and_b32 v38, s14, v38
  v_and_b32 v39, s14, v39
  s_mov_b64 exec, vcc
  v_xor_b32 v63, 2, v63
  s_cmp_le_u32 s10, 2
  s_cbranch_scc1 L_pc2
  s_mov_b64 exec, s[40:41]
  s_waitcnt vmcnt(2)
  v_msad_u8 v78, v40, s72, v78
  v_msad_u8 v78, v41, s73, v78
  v_msad_u8 v78, v42, s74, v78
  v_msad_u8 v78, v43, s75, v78
  v_cmp_eq_u32 vcc, 0, v78
  v_and_b32 v40, s14, v40
  v_and_b32 v41, s14, v41
  v_and_b32 v42, s14, v42
  v_and_b32 v43, s14, v43
  s_mov_b64 exec, vcc
  v_xor_b32 v63, 4, v63
  s_mov_b64 exec, s[42:43]
  s_waitcnt vmcnt(1)
  v_msad_u8 v79, v44, s72, v79
  v_msad_u8 v79, v45, s73, v79
  v_msad_u8 v79, v46, s74, v79
  v_msad_u8 v79, v47, s75, v79
  v_cmp_eq_u32 vcc, 0, v79
  v_and_b32 v44, s14, v44
  v_and_b32 v45, s14, v45
  v_and_b32 v46, s14, v46
  v_and_b32 v47, s14, v47
  s_mov_b64 exec, vcc
  v_xor_b32 v63, 8, v63
L_pc2:
  s_mov_b64 exec, s[18:19]
  s_waitcnt vmcnt(0)
  v_cmp_ne_u32 s[18:19], s70, v70
  v_cmp_ne_u32 vcc, s71, v71
  s_mov_b64 exec, -1
  s_or_b64 s[18:19], s[18:19], vcc
  v_cmp_ne_u32 vcc, 0, v63
  s_or_b64 s[12:13], s[18:19], vcc
  s_cbranch_scc0 L_pdone
  s_cmp_eq_u32 s94, 0
  s_cbranch_scc1 L_pdone
  s_bcnt1_i32_b64 s93, s[44:45]
  s_cmp_le_u32 s93, 1
  s_cselect_b64 s[12:13], 0, s[44:45]
  v_cndmask_b32 v68, -1, 0, s[12:13]
  s_nop 1
L_wreg_7:
L_pad_15:
  s_cbranch_execz L_pad_16
  v_and_b32_dpp v76, v68, v63 row_newbcast:0 row_mask:0xf bank_mask:0xf
  v_and_b32_dpp v77, v68, v63 row_newbcast:1 row_mask:0xf bank_mask:0xf
  v_and_b32_dpp v78, v68, v63 row_newbcast:2 row_mask:0xf bank_mask:0xf
  v_and_b32_dpp v79, v68, v63 row_newbcast:3 row_mask:0xf bank_mask:0xf
  v_and_b32 v76, 1, v76
  v_and_b32 v77, 2, v77
  v_and_b32 v78, 4, v78
  v_and_b32 v79, 8, v79
  v_cmp_ne_u32 s[36:37], 0, v76
  v_cmp_ne_u32 s[38:39], 0, v77
  v_cmp_ne_u32 s[40:41], 0, v78
  v_cmp_ne_u32 s[42:43], 0, v79
  s_branch L_poll
L_pdone:
  v_max_f32_dpp v2, v56, v56 quad_perm:[1,0,3,2] row_mask:0xf bank_mask:0xf
  s_nop 1
  v_max_f32_dpp v2, v2, v2 quad_perm:[2,3,0,1] row_mask:0xf bank_mask:0xf
  v_mov_b32 v3, v2
  s_nop 1
  v_permlane32_swap_b32 v2, v3
  v_max_f32 v2, v2, v3
  v_mov_b32 v3, v2
  s_nop 1
  v_permlane16_swap_b32 v2, v3
  v_max_f32 v28, v2, v3
  v_sub_f32 v53, v56, v28
  v_mul_f32 v53, s8, v53
  v_exp_f32 v53, v53
  s_cmp_le_u32 s10, 2
  v_mul_f32 v21, v53, v57
  s_nop 0
  v_mul_f32_dpp v64, v53, v32 row_newbcast:0 row_mask:0xf bank_mask:0xf
  v_mul_f32_dpp v65, v53, v33 row_newbcast:0 row_mask:0xf bank_mask:0xf
  v_mul_f32_dpp v66, v53, v34 row_newbcast:0 row_mask:0xf bank_mask:0xf
  v_mul_f32_dpp v67, v53, v35 row_newbcast:0 row_mask:0xf bank_mask:0xf
  v_add_f32_dpp v21, v21, v21 quad_perm:[1,0,3,2] row_mask:0xf bank_mask:0xf
  v_fmac_f32_dpp v64, v53, v36 row_newbcast:1 row_mask:0xf bank_mask:0xf
  v_fmac_f32_dpp v65, v53, v37 row_newbcast:1 row_mask:0xf bank_mask:0xf
  v_fmac_f32_dpp v66, v53, v38 row_newbcast:1 row_mask:0xf bank_mask:0xf
  v_fmac_f32_dpp v67, v53, v39 row_newbcast:1 row_mask:0xf bank_mask:0xf
  v_add_f32_dpp v21, v21, v21 quad_perm:[2,3,0,1] row_mask:0xf bank_mask:0xf
  s_cbranch_scc1 L_cm
  v_fmac_f32_dpp v64, v53, v40 row_newbcast:2 row_mask:0xf bank_mask:0xf
  v_fmac_f32_dpp v65, v53, v41 row_newbcast:2 row_mask:0xf bank_mask:0xf
  v_fmac_f32_dpp v66, v53, v42 row_newbcast:2 row_mask:0xf bank_mask:0xf
  v_fmac_f32_dpp v67, v53, v43 row_newbcast:2 row_mask:0xf bank_mask:0xf
  v_fmac_f32_dpp v64, v53, v44 row_newbcast:3 row_mask:0xf bank_mask:0xf
  v_fmac_f32_dpp v65, v53, v45 row_newbcast:3 row_mask:0xf bank_mask:0xf
  v_fmac_f32_dpp v66, v53, v46 row_newbcast:3 row_mask:0xf bank_mask:0xf
  v_fmac_f32_dpp v67, v53, v47 row_newbcast:3 row_mask:0xf bank_mask:0xf
L_cm:
  v_mov_b32 v22, v21
  s_nop 0
  v_permlane32_swap_b32 v64, v65
  v_permlane32_swap_b32 v66, v67
  v_permlane32_swap_b32 v21, v22
  v_add_f32 v64, v64, v65
  v_add_f32 v66, v66, v67
  v_add_f32 v21, v21, v22
  v_mov_b32 v22, v21
  s_nop 0
  v_permlane16_swap_b32 v64, v66
  s_nop 0
  v_permlane16_swap_b32 v21, v22
  v_add_f32 v64, v64, v66
  v_add_f32 v29, v21, v22
  ds_write_b32 v72, v64 offset:3328
  s_mov_b64 exec, 1
  ds_write_b64 v73, v[28:29] offset:1216
  s_mov_b64 exec, -1
  s_cmp_lg_u32 s4, 0
  s_waitcnt lgkmcnt(0)
  s_barrier
  s_cbranch_scc1 L_end
  ds_read_b128 v[76:79], v30 offset:1216
  ds_read_b128 v[80:83], v30 offset:1232
  ds_read2st64_b32 v[84:85], v72 offset0:13 offset1:14
  ds_read2st64_b32 v[86:87], v72 offset0:15 offset1:16
  s_waitcnt lgkmcnt(2)
  v_max3_f32 v2, v76, v78, v80
  v_max_f32 v2, v2, v82
  v_sub_f32 v76, v76, v2
  v_sub_f32 v78, v78, v2
  v_sub_f32 v80, v80, v2
  v_sub_f32 v82, v82, v2
  v_mul_f32 v76, s8, v76
  v_mul_f32 v78, s8, v78
  v_mul_f32 v80, s8, v80
  v_mul_f32 v82, s8, v82
  v_exp_f32 v76, v76
  v_exp_f32 v78, v78
  v_exp_f32 v80, v80
  v_exp_f32 v82, v82
L_pad_16:
  s_cbranch_execz L_wreth
  s_waitcnt lgkmcnt(0)
  v_mul_f32 v21, v76, v77
  v_mul_f32 v22, v76, v84
  v_fmac_f32 v21, v78, v79
  v_fmac_f32 v22, v78, v85
  v_fmac_f32 v21, v80, v81
  v_fmac_f32 v22, v80, v86
  v_fmac_f32 v21, v82, v83
  v_fmac_f32 v22, v82, v87
  v_rcp_f32 v21, v21
  s_cmp_lg_u32 s6, 0
  v_mul_f32 v22, v22, v21
  v_cvt_pk_bf16_f32 v22, v22, v22
  global_store_short v54, v22, s[26:27]
  s_cbranch_scc1 L_end
  s_add_u32 s93, s76, 1
  s_and_b32 s92, s93, 0xff
  s_cmp_eq_u32 s92, 0
  s_addc_u32 s93, s93, 0
  s_lshl_b32 s92, s7, 7
  v_mov_b32 v2, s92
  v_mov_b32 v3, s93
  s_mov_b64 exec, 1
  global_store_dword v2, v3, s[30:31] sc1
L_end:
  s_endpgm
.section .rodata,"a"
.p2align 6
.amdhsa_kernel standalone__paged_block_table_kv_radixattention__decode_kernel
  .amdhsa_next_free_vgpr 140
  .amdhsa_next_free_sgpr 102
  .amdhsa_accum_offset 140
  .amdhsa_group_segment_fixed_size 0
  .amdhsa_kernarg_size 64
  .amdhsa_user_sgpr_count 2
  .amdhsa_user_sgpr_kernarg_segment_ptr 1
  .amdhsa_system_sgpr_workgroup_id_x 1
.end_amdhsa_kernel
```
